```python
import torch

def _softmax(x, axis=-1):
    return torch.softmax(x, dim=axis)
def _gelu(x):
    return torch.nn.functional.gelu(x, approximate="tanh")
def _silu(x):
    return torch.nn.functional.silu(x)
def _sigmoid(x):
    return torch.sigmoid(x)
def _layernorm(x, axis=-1, eps=1e-5):
    m = x.mean(dim=axis, keepdim=True)
    v = x.var(dim=axis, keepdim=True, unbiased=False)
    return (x - m) / torch.sqrt(v + eps)
def _scatter_add(tgt, idx, src, axis=0):
    return tgt.clone().index_add_(axis, idx, src)
def _segment_sum(src, seg, n):
    out = torch.zeros((n,) + src.shape[1:], dtype=src.dtype)
    return out.index_add_(0, seg, src)
def _pad(x, pw):
    flat = tuple(v for pair in reversed(pw) for v in pair)
    return torch.nn.functional.pad(x, flat)

kernel_name = 'standalone__fused_bias_dropout_add__prompt'

def setup_inputs():

    _w = (lambda a: (lambda t: t.to(torch.bfloat16) if t.is_floating_point() else t)(torch.as_tensor(a)))
    B, S, D = 4, 2048, 448
    keep = 0.9
    mask = (torch.rand(B, S, D) < keep).to(float)
    return {
        "x": _w((lambda *s: torch.randn(*s, dtype=torch.bfloat16) * 0.05)(B, S, D)),
        "bias": _w((lambda *s: torch.randn(*s, dtype=torch.bfloat16) * 0.05)(D)),
        "mask": _w(mask),
        "residual": _w((lambda *s: torch.randn(*s, dtype=torch.bfloat16) * 0.05)(B, S, D)),
    }

def reference(x, bias, mask, residual):
    keep = 0.9
    return residual + (x + bias) * mask * (1.0 / keep)
```

```asm
; @launch grid=(256,1,1) block=(256,1,1) lds=0
.amdgcn_target "amdgcn-amd-amdhsa--gfx950"
.text
.globl standalone__fused_bias_dropout_add__prompt_kernel
.p2align 12
.p2align 8
.type standalone__fused_bias_dropout_add__prompt_kernel,@function
standalone__fused_bias_dropout_add__prompt_kernel:
    s_load_dwordx8 s[4:11], s[0:1], 0
    s_load_dwordx2 s[12:13], s[0:1], 32
    s_cmp_ge_u32 s2, 256
    s_cbranch_scc1 L_exit
    s_mul_i32 s3, s2, 28672
    s_add_u32 s3, s3, 3584
    v_and_b32 v2, 63, v0
    v_cmp_gt_u32 vcc, 56, v2
    v_lshlrev_b32 v2, 4, v2
    v_lshrrev_b32 v0, 6, v0
    v_mul_u32_u24 v0, 7168, v0
    v_add3_u32 v1, v0, v2, s3
    s_and_b64 exec, exec, vcc
    s_mov_b32 s14, 0x3f8e38e4
    s_mov_b32 s15, 0xffff0000
    s_waitcnt lgkmcnt(0)
    global_load_dwordx4 v[4:7], v2, s[6:7]
    global_load_dwordx4 v[8:11], v1, s[4:5] offset:-3584 nt
    global_load_dwordx4 v[12:15], v1, s[8:9] offset:-3584 nt
    global_load_dwordx4 v[16:19], v1, s[10:11] offset:-3584 nt
    global_load_dwordx4 v[20:23], v1, s[4:5] offset:-2688 nt
    global_load_dwordx4 v[24:27], v1, s[8:9] offset:-2688 nt
    global_load_dwordx4 v[28:31], v1, s[10:11] offset:-2688 nt
    global_load_dwordx4 v[32:35], v1, s[4:5] offset:-1792 nt
    global_load_dwordx4 v[36:39], v1, s[8:9] offset:-1792 nt
    global_load_dwordx4 v[40:43], v1, s[10:11] offset:-1792 nt
    global_load_dwordx4 v[44:47], v1, s[4:5] offset:-896 nt
    global_load_dwordx4 v[48:51], v1, s[8:9] offset:-896 nt
    global_load_dwordx4 v[52:55], v1, s[10:11] offset:-896 nt
    global_load_dwordx4 v[56:59], v1, s[4:5] nt
    global_load_dwordx4 v[60:63], v1, s[8:9] nt
    global_load_dwordx4 v[64:67], v1, s[10:11] nt
    s_waitcnt vmcnt(15)
    v_lshlrev_b32 v104, 16, v4
    v_and_b32 v105, s15, v4
    v_pk_mul_f32 v[104:105], v[104:105], s[14:15] op_sel_hi:[1,0]
    v_lshlrev_b32 v106, 16, v5
    v_and_b32 v107, s15, v5
    v_pk_mul_f32 v[106:107], v[106:107], s[14:15] op_sel_hi:[1,0]
    v_lshlrev_b32 v108, 16, v6
    v_and_b32 v109, s15, v6
    v_pk_mul_f32 v[108:109], v[108:109], s[14:15] op_sel_hi:[1,0]
    v_lshlrev_b32 v110, 16, v7
    v_and_b32 v111, s15, v7
    v_pk_mul_f32 v[110:111], v[110:111], s[14:15] op_sel_hi:[1,0]
    s_waitcnt vmcnt(13)
    global_load_dwordx4 v[68:71], v1, s[4:5] offset:896 nt
    global_load_dwordx4 v[72:75], v1, s[8:9] offset:896 nt
    global_load_dwordx4 v[76:79], v1, s[10:11] offset:896 nt
    v_lshlrev_b32 v112, 16, v8
    v_and_b32 v113, s15, v8
    v_lshlrev_b32 v114, 16, v12
    v_and_b32 v115, s15, v12
    v_pk_fma_f32 v[112:113], v[112:113], s[14:15], v[104:105] op_sel_hi:[1,0,1]
    v_lshlrev_b32 v116, 16, v9
    v_and_b32 v117, s15, v9
    v_lshlrev_b32 v118, 16, v13
    v_and_b32 v119, s15, v13
    v_pk_fma_f32 v[116:117], v[116:117], s[14:15], v[106:107] op_sel_hi:[1,0,1]
    v_lshlrev_b32 v120, 16, v10
    v_and_b32 v121, s15, v10
    v_lshlrev_b32 v122, 16, v14
    v_and_b32 v123, s15, v14
    v_pk_fma_f32 v[120:121], v[120:121], s[14:15], v[108:109] op_sel_hi:[1,0,1]
    v_lshlrev_b32 v124, 16, v11
    v_and_b32 v125, s15, v11
    v_lshlrev_b32 v126, 16, v15
    v_and_b32 v127, s15, v15
    v_pk_fma_f32 v[124:125], v[124:125], s[14:15], v[110:111] op_sel_hi:[1,0,1]
    s_waitcnt vmcnt(15)
    v_lshlrev_b32 v12, 16, v16
    v_and_b32 v13, s15, v16
    v_pk_fma_f32 v[112:113], v[112:113], v[114:115], v[12:13]
    v_cvt_pk_bf16_f32 v8, v112, v113
    v_lshlrev_b32 v14, 16, v17
    v_and_b32 v15, s15, v17
    v_pk_fma_f32 v[116:117], v[116:117], v[118:119], v[14:15]
    v_cvt_pk_bf16_f32 v9, v116, v117
    v_lshlrev_b32 v12, 16, v18
    v_and_b32 v13, s15, v18
    v_pk_fma_f32 v[120:121], v[120:121], v[122:123], v[12:13]
    v_cvt_pk_bf16_f32 v10, v120, v121
    v_lshlrev_b32 v14, 16, v19
    v_and_b32 v15, s15, v19
    v_pk_fma_f32 v[124:125], v[124:125], v[126:127], v[14:15]
    v_cvt_pk_bf16_f32 v11, v124, v125
    global_store_dwordx4 v1, v[8:11], s[12:13] offset:-3584
    s_waitcnt vmcnt(14)
    global_load_dwordx4 v[80:83], v1, s[4:5] offset:1792 nt
    global_load_dwordx4 v[84:87], v1, s[8:9] offset:1792 nt
    global_load_dwordx4 v[88:91], v1, s[10:11] offset:1792 nt
    v_lshlrev_b32 v112, 16, v20
    v_and_b32 v113, s15, v20
    v_lshlrev_b32 v114, 16, v24
    v_and_b32 v115, s15, v24
    v_pk_fma_f32 v[112:113], v[112:113], s[14:15], v[104:105] op_sel_hi:[1,0,1]
    v_lshlrev_b32 v116, 16, v21
    v_and_b32 v117, s15, v21
    v_lshlrev_b32 v118, 16, v25
    v_and_b32 v119, s15, v25
    v_pk_fma_f32 v[116:117], v[116:117], s[14:15], v[106:107] op_sel_hi:[1,0,1]
    v_lshlrev_b32 v120, 16, v22
    v_and_b32 v121, s15, v22
    v_lshlrev_b32 v122, 16, v26
    v_and_b32 v123, s15, v26
    v_pk_fma_f32 v[120:121], v[120:121], s[14:15], v[108:109] op_sel_hi:[1,0,1]
    v_lshlrev_b32 v124, 16, v23
    v_and_b32 v125, s15, v23
    v_lshlrev_b32 v126, 16, v27
    v_and_b32 v127, s15, v27
    v_pk_fma_f32 v[124:125], v[124:125], s[14:15], v[110:111] op_sel_hi:[1,0,1]
    s_waitcnt vmcnt(16)
    v_lshlrev_b32 v24, 16, v28
    v_and_b32 v25, s15, v28
    v_pk_fma_f32 v[112:113], v[112:113], v[114:115], v[24:25]
    v_cvt_pk_bf16_f32 v20, v112, v113
    v_lshlrev_b32 v26, 16, v29
    v_and_b32 v27, s15, v29
    v_pk_fma_f32 v[116:117], v[116:117], v[118:119], v[26:27]
    v_cvt_pk_bf16_f32 v21, v116, v117
    v_lshlrev_b32 v24, 16, v30
    v_and_b32 v25, s15, v30
    v_pk_fma_f32 v[120:121], v[120:121], v[122:123], v[24:25]
    v_cvt_pk_bf16_f32 v22, v120, v121
    v_lshlrev_b32 v26, 16, v31
    v_and_b32 v27, s15, v31
    v_pk_fma_f32 v[124:125], v[124:125], v[126:127], v[26:27]
    v_cvt_pk_bf16_f32 v23, v124, v125
    global_store_dwordx4 v1, v[20:23], s[12:13] offset:-2688
    s_waitcnt vmcnt(15)
    global_load_dwordx4 v[92:95], v1, s[4:5] offset:2688 nt
    global_load_dwordx4 v[96:99], v1, s[8:9] offset:2688 nt
    global_load_dwordx4 v[100:103], v1, s[10:11] offset:2688 nt
    v_lshlrev_b32 v112, 16, v32
    v_and_b32 v113, s15, v32
    v_lshlrev_b32 v114, 16, v36
    v_and_b32 v115, s15, v36
    v_pk_fma_f32 v[112:113], v[112:113], s[14:15], v[104:105] op_sel_hi:[1,0,1]
    v_lshlrev_b32 v116, 16, v33
    v_and_b32 v117, s15, v33
    v_lshlrev_b32 v118, 16, v37
    v_and_b32 v119, s15, v37
    v_pk_fma_f32 v[116:117], v[116:117], s[14:15], v[106:107] op_sel_hi:[1,0,1]
    v_lshlrev_b32 v120, 16, v34
    v_and_b32 v121, s15, v34
    v_lshlrev_b32 v122, 16, v38
    v_and_b32 v123, s15, v38
    v_pk_fma_f32 v[120:121], v[120:121], s[14:15], v[108:109] op_sel_hi:[1,0,1]
    v_lshlrev_b32 v124, 16, v35
    v_and_b32 v125, s15, v35
    v_lshlrev_b32 v126, 16, v39
    v_and_b32 v127, s15, v39
    v_pk_fma_f32 v[124:125], v[124:125], s[14:15], v[110:111] op_sel_hi:[1,0,1]
    s_waitcnt vmcnt(17)
    v_lshlrev_b32 v36, 16, v40
    v_and_b32 v37, s15, v40
    v_pk_fma_f32 v[112:113], v[112:113], v[114:115], v[36:37]
    v_cvt_pk_bf16_f32 v32, v112, v113
    v_lshlrev_b32 v38, 16, v41
    v_and_b32 v39, s15, v41
    v_pk_fma_f32 v[116:117], v[116:117], v[118:119], v[38:39]
    v_cvt_pk_bf16_f32 v33, v116, v117
    v_lshlrev_b32 v36, 16, v42
    v_and_b32 v37, s15, v42
    v_pk_fma_f32 v[120:121], v[120:121], v[122:123], v[36:37]
    v_cvt_pk_bf16_f32 v34, v120, v121
    v_lshlrev_b32 v38, 16, v43
    v_and_b32 v39, s15, v43
    v_pk_fma_f32 v[124:125], v[124:125], v[126:127], v[38:39]
    v_cvt_pk_bf16_f32 v35, v124, v125
    global_store_dwordx4 v1, v[32:35], s[12:13] offset:-1792
    s_waitcnt vmcnt(16)
    v_lshlrev_b32 v112, 16, v44
    v_and_b32 v113, s15, v44
    v_lshlrev_b32 v114, 16, v48
    v_and_b32 v115, s15, v48
    v_pk_fma_f32 v[112:113], v[112:113], s[14:15], v[104:105] op_sel_hi:[1,0,1]
    v_lshlrev_b32 v116, 16, v45
    v_and_b32 v117, s15, v45
    v_lshlrev_b32 v118, 16, v49
    v_and_b32 v119, s15, v49
    v_pk_fma_f32 v[116:117], v[116:117], s[14:15], v[106:107] op_sel_hi:[1,0,1]
    v_lshlrev_b32 v120, 16, v46
    v_and_b32 v121, s15, v46
    v_lshlrev_b32 v122, 16, v50
    v_and_b32 v123, s15, v50
    v_pk_fma_f32 v[120:121], v[120:121], s[14:15], v[108:109] op_sel_hi:[1,0,1]
    v_lshlrev_b32 v124, 16, v47
    v_and_b32 v125, s15, v47
    v_lshlrev_b32 v126, 16, v51
    v_and_b32 v127, s15, v51
    v_pk_fma_f32 v[124:125], v[124:125], s[14:15], v[110:111] op_sel_hi:[1,0,1]
    s_waitcnt vmcnt(15)
    v_lshlrev_b32 v48, 16, v52
    v_and_b32 v49, s15, v52
    v_pk_fma_f32 v[112:113], v[112:113], v[114:115], v[48:49]
    v_cvt_pk_bf16_f32 v44, v112, v113
    v_lshlrev_b32 v50, 16, v53
    v_and_b32 v51, s15, v53
    v_pk_fma_f32 v[116:117], v[116:117], v[118:119], v[50:51]
    v_cvt_pk_bf16_f32 v45, v116, v117
    v_lshlrev_b32 v48, 16, v54
    v_and_b32 v49, s15, v54
    v_pk_fma_f32 v[120:121], v[120:121], v[122:123], v[48:49]
    v_cvt_pk_bf16_f32 v46, v120, v121
    v_lshlrev_b32 v50, 16, v55
    v_and_b32 v51, s15, v55
    v_pk_fma_f32 v[124:125], v[124:125], v[126:127], v[50:51]
    v_cvt_pk_bf16_f32 v47, v124, v125
    global_store_dwordx4 v1, v[44:47], s[12:13] offset:-896
    s_waitcnt vmcnt(14)
    v_lshlrev_b32 v112, 16, v56
    v_and_b32 v113, s15, v56
    v_lshlrev_b32 v114, 16, v60
    v_and_b32 v115, s15, v60
    v_pk_fma_f32 v[112:113], v[112:113], s[14:15], v[104:105] op_sel_hi:[1,0,1]
    v_lshlrev_b32 v116, 16, v57
    v_and_b32 v117, s15, v57
    v_lshlrev_b32 v118, 16, v61
    v_and_b32 v119, s15, v61
    v_pk_fma_f32 v[116:117], v[116:117], s[14:15], v[106:107] op_sel_hi:[1,0,1]
    v_lshlrev_b32 v120, 16, v58
    v_and_b32 v121, s15, v58
    v_lshlrev_b32 v122, 16, v62
    v_and_b32 v123, s15, v62
    v_pk_fma_f32 v[120:121], v[120:121], s[14:15], v[108:109] op_sel_hi:[1,0,1]
    v_lshlrev_b32 v124, 16, v59
    v_and_b32 v125, s15, v59
    v_lshlrev_b32 v126, 16, v63
    v_and_b32 v127, s15, v63
    v_pk_fma_f32 v[124:125], v[124:125], s[14:15], v[110:111] op_sel_hi:[1,0,1]
    s_waitcnt vmcnt(13)
    v_lshlrev_b32 v60, 16, v64
    v_and_b32 v61, s15, v64
    v_pk_fma_f32 v[112:113], v[112:113], v[114:115], v[60:61]
    v_cvt_pk_bf16_f32 v56, v112, v113
    v_lshlrev_b32 v62, 16, v65
    v_and_b32 v63, s15, v65
    v_pk_fma_f32 v[116:117], v[116:117], v[118:119], v[62:63]
    v_cvt_pk_bf16_f32 v57, v116, v117
    v_lshlrev_b32 v60, 16, v66
    v_and_b32 v61, s15, v66
    v_pk_fma_f32 v[120:121], v[120:121], v[122:123], v[60:61]
    v_cvt_pk_bf16_f32 v58, v120, v121
    v_lshlrev_b32 v62, 16, v67
    v_and_b32 v63, s15, v67
    v_pk_fma_f32 v[124:125], v[124:125], v[126:127], v[62:63]
    v_cvt_pk_bf16_f32 v59, v124, v125
    global_store_dwordx4 v1, v[56:59], s[12:13]
    s_waitcnt vmcnt(12)
    v_lshlrev_b32 v112, 16, v68
    v_and_b32 v113, s15, v68
    v_lshlrev_b32 v114, 16, v72
    v_and_b32 v115, s15, v72
    v_pk_fma_f32 v[112:113], v[112:113], s[14:15], v[104:105] op_sel_hi:[1,0,1]
    v_lshlrev_b32 v116, 16, v69
    v_and_b32 v117, s15, v69
    v_lshlrev_b32 v118, 16, v73
    v_and_b32 v119, s15, v73
    v_pk_fma_f32 v[116:117], v[116:117], s[14:15], v[106:107] op_sel_hi:[1,0,1]
    v_lshlrev_b32 v120, 16, v70
    v_and_b32 v121, s15, v70
    v_lshlrev_b32 v122, 16, v74
    v_and_b32 v123, s15, v74
    v_pk_fma_f32 v[120:121], v[120:121], s[14:15], v[108:109] op_sel_hi:[1,0,1]
    v_lshlrev_b32 v124, 16, v71
    v_and_b32 v125, s15, v71
    v_lshlrev_b32 v126, 16, v75
    v_and_b32 v127, s15, v75
    v_pk_fma_f32 v[124:125], v[124:125], s[14:15], v[110:111] op_sel_hi:[1,0,1]
    s_waitcnt vmcnt(11)
    v_lshlrev_b32 v72, 16, v76
    v_and_b32 v73, s15, v76
    v_pk_fma_f32 v[112:113], v[112:113], v[114:115], v[72:73]
    v_cvt_pk_bf16_f32 v68, v112, v113
    v_lshlrev_b32 v74, 16, v77
    v_and_b32 v75, s15, v77
    v_pk_fma_f32 v[116:117], v[116:117], v[118:119], v[74:75]
    v_cvt_pk_bf16_f32 v69, v116, v117
    v_lshlrev_b32 v72, 16, v78
    v_and_b32 v73, s15, v78
    v_pk_fma_f32 v[120:121], v[120:121], v[122:123], v[72:73]
    v_cvt_pk_bf16_f32 v70, v120, v121
    v_lshlrev_b32 v74, 16, v79
    v_and_b32 v75, s15, v79
    v_pk_fma_f32 v[124:125], v[124:125], v[126:127], v[74:75]
    v_cvt_pk_bf16_f32 v71, v124, v125
    global_store_dwordx4 v1, v[68:71], s[12:13] offset:896
    s_waitcnt vmcnt(9)
    v_lshlrev_b32 v112, 16, v80
    v_and_b32 v113, s15, v80
    v_lshlrev_b32 v114, 16, v84
    v_and_b32 v115, s15, v84
    v_pk_fma_f32 v[112:113], v[112:113], s[14:15], v[104:105] op_sel_hi:[1,0,1]
    v_lshlrev_b32 v116, 16, v81
    v_and_b32 v117, s15, v81
    v_lshlrev_b32 v118, 16, v85
    v_and_b32 v119, s15, v85
    v_pk_fma_f32 v[116:117], v[116:117], s[14:15], v[106:107] op_sel_hi:[1,0,1]
    v_lshlrev_b32 v120, 16, v82
    v_and_b32 v121, s15, v82
    v_lshlrev_b32 v122, 16, v86
    v_and_b32 v123, s15, v86
    v_pk_fma_f32 v[120:121], v[120:121], s[14:15], v[108:109] op_sel_hi:[1,0,1]
    v_lshlrev_b32 v124, 16, v83
    v_and_b32 v125, s15, v83
    v_lshlrev_b32 v126, 16, v87
    v_and_b32 v127, s15, v87
    v_pk_fma_f32 v[124:125], v[124:125], s[14:15], v[110:111] op_sel_hi:[1,0,1]
    s_waitcnt vmcnt(8)
    v_lshlrev_b32 v84, 16, v88
    v_and_b32 v85, s15, v88
    v_pk_fma_f32 v[112:113], v[112:113], v[114:115], v[84:85]
    v_cvt_pk_bf16_f32 v80, v112, v113
    v_lshlrev_b32 v86, 16, v89
    v_and_b32 v87, s15, v89
    v_pk_fma_f32 v[116:117], v[116:117], v[118:119], v[86:87]
    v_cvt_pk_bf16_f32 v81, v116, v117
    v_lshlrev_b32 v84, 16, v90
    v_and_b32 v85, s15, v90
    v_pk_fma_f32 v[120:121], v[120:121], v[122:123], v[84:85]
    v_cvt_pk_bf16_f32 v82, v120, v121
    v_lshlrev_b32 v86, 16, v91
    v_and_b32 v87, s15, v91
    v_pk_fma_f32 v[124:125], v[124:125], v[126:127], v[86:87]
    v_cvt_pk_bf16_f32 v83, v124, v125
    global_store_dwordx4 v1, v[80:83], s[12:13] offset:1792
    s_waitcnt vmcnt(6)
    v_lshlrev_b32 v112, 16, v92
    v_and_b32 v113, s15, v92
    v_lshlrev_b32 v114, 16, v96
    v_and_b32 v115, s15, v96
    v_pk_fma_f32 v[112:113], v[112:113], s[14:15], v[104:105] op_sel_hi:[1,0,1]
    v_lshlrev_b32 v116, 16, v93
    v_and_b32 v117, s15, v93
    v_lshlrev_b32 v118, 16, v97
    v_and_b32 v119, s15, v97
    v_pk_fma_f32 v[116:117], v[116:117], s[14:15], v[106:107] op_sel_hi:[1,0,1]
    v_lshlrev_b32 v120, 16, v94
    v_and_b32 v121, s15, v94
    v_lshlrev_b32 v122, 16, v98
    v_and_b32 v123, s15, v98
    v_pk_fma_f32 v[120:121], v[120:121], s[14:15], v[108:109] op_sel_hi:[1,0,1]
    v_lshlrev_b32 v124, 16, v95
    v_and_b32 v125, s15, v95
    v_lshlrev_b32 v126, 16, v99
    v_and_b32 v127, s15, v99
    v_pk_fma_f32 v[124:125], v[124:125], s[14:15], v[110:111] op_sel_hi:[1,0,1]
    s_waitcnt vmcnt(5)
    v_lshlrev_b32 v96, 16, v100
    v_and_b32 v97, s15, v100
    v_pk_fma_f32 v[112:113], v[112:113], v[114:115], v[96:97]
    v_cvt_pk_bf16_f32 v92, v112, v113
    v_lshlrev_b32 v98, 16, v101
    v_and_b32 v99, s15, v101
    v_pk_fma_f32 v[116:117], v[116:117], v[118:119], v[98:99]
    v_cvt_pk_bf16_f32 v93, v116, v117
    v_lshlrev_b32 v96, 16, v102
    v_and_b32 v97, s15, v102
    v_pk_fma_f32 v[120:121], v[120:121], v[122:123], v[96:97]
    v_cvt_pk_bf16_f32 v94, v120, v121
    v_lshlrev_b32 v98, 16, v103
    v_and_b32 v99, s15, v103
    v_pk_fma_f32 v[124:125], v[124:125], v[126:127], v[98:99]
    v_cvt_pk_bf16_f32 v95, v124, v125
    global_store_dwordx4 v1, v[92:95], s[12:13] offset:2688
L_end:
    s_endpgm
L_exit:
    s_waitcnt lgkmcnt(0)
    s_endpgm
.section .rodata,"a"
.p2align 6
.amdhsa_kernel standalone__fused_bias_dropout_add__prompt_kernel
  .amdhsa_next_free_vgpr 130
  .amdhsa_next_free_sgpr 18
  .amdhsa_accum_offset 132
  .amdhsa_group_segment_fixed_size 0
  .amdhsa_kernarg_size 56
  .amdhsa_user_sgpr_count 2
  .amdhsa_user_sgpr_kernarg_segment_ptr 1
  .amdhsa_system_sgpr_workgroup_id_x 1
  .amdhsa_float_denorm_mode_32 3
.end_amdhsa_kernel
```
